```python
import torch

def _softmax(x, axis=-1):
    return torch.softmax(x, dim=axis)
def _gelu(x):
    return torch.nn.functional.gelu(x, approximate="tanh")
def _silu(x):
    return torch.nn.functional.silu(x)
def _sigmoid(x):
    return torch.sigmoid(x)
def _layernorm(x, axis=-1, eps=1e-5):
    m = x.mean(dim=axis, keepdim=True)
    v = x.var(dim=axis, keepdim=True, unbiased=False)
    return (x - m) / torch.sqrt(v + eps)
def _scatter_add(tgt, idx, src, axis=0):
    return tgt.clone().index_add_(axis, idx, src)
def _segment_sum(src, seg, n):
    out = torch.zeros((n,) + src.shape[1:], dtype=src.dtype)
    return out.index_add_(0, seg, src)
def _pad(x, pw):
    flat = tuple(v for pair in reversed(pw) for v in pair)
    return torch.nn.functional.pad(x, flat)

kernel_name = 'standalone__paged_block_table_kv_pagedattention__sampling'

def setup_inputs():

    _w = (lambda a: (lambda t: t.to(torch.bfloat16) if t.is_floating_point() else t)(torch.as_tensor(a)))
    B, Hq, Hkv, Sq, Skv, D = 32, 32, 8, 4, 2048, 128
    bs = 16
    nbps = max(1, Skv // bs)
    num_phys = B * nbps + 4
    bt = torch.randperm(num_phys)[: B * nbps].reshape(B, nbps).to(torch.int64)
    cl = (nbps * bs - (torch.arange(1, B + 1, dtype=torch.int64) * 2654435761) % max(1, nbps * bs // 2)).to(torch.int64)
    return {
        "q": _w((lambda *s: torch.randn(*s, dtype=torch.bfloat16) * 0.8)(B, Hq, Sq, D)),
        "k_cache": _w((lambda *s: torch.randn(*s, dtype=torch.bfloat16) * 0.8)(num_phys, bs, Hkv, D)),
        "v_cache": _w((lambda *s: torch.randn(*s, dtype=torch.bfloat16) * 0.05)(num_phys, bs, Hkv, D)),
        "block_table": _w(bt),
        "context_lens": _w(cl),
    }

def reference(q, k_cache, v_cache, block_table, context_lens):
    B, Hq, Sq, D = q.shape
    bs = k_cache.shape[1]
    Hkv = k_cache.shape[2]
    nbps = block_table.shape[1]
    Skv = nbps * bs
    bt = block_table.reshape(-1)
    k = (lambda x, *d: x.permute(*d))(k_cache[bt].reshape(B, Skv, Hkv, D), 0, 2, 1, 3)
    v = (lambda x, *d: x.permute(*d))(v_cache[bt].reshape(B, Skv, Hkv, D), 0, 2, 1, 3)
    g = Hq // Hkv
    qg = q.reshape(B, Hkv, g, Sq, D)
    scores = torch.einsum("bhgqd,bhkd->bhgqk", qg, k) * (D ** -0.5)
    pos = torch.arange(Skv)
    msk = pos[None, :] < context_lens[:, None]
    scores = torch.where(msk[:, None, None, None, :], scores, -1e9)
    p = _softmax(scores, axis=-1)
    out = torch.einsum("bhgqk,bhkd->bhgqd", p, v)
    return out.reshape(B, Hq, Sq, D)
```

```asm
; @launch grid=(256,1,1) block=(256,1,1) lds=81728
.amdgcn_target "amdgcn-amd-amdhsa--gfx950"
.text
.globl standalone__paged_block_table_kv_pagedattention__sampling_kernel
.p2align 8
.type standalone__paged_block_table_kv_pagedattention__sampling_kernel,@function
standalone__paged_block_table_kv_pagedattention__sampling_kernel:
  s_cmp_ge_u32 s2, 256
  s_cbranch_scc1 L_end
  s_load_dwordx8 s[4:11], s[0:1], 0
  s_load_dwordx4 s[12:15], s[0:1], 32
  s_load_dwordx4 s[88:91], s[0:1], 48
  v_lshrrev_b32 v25, 6, v0
  v_and_b32 v0, 63, v0
  v_readfirstlane_b32 s42, v25
  s_lshr_b32 s40, s2, 3
  s_and_b32 s41, s2, 7
  v_and_b32 v27, 15, v0
  v_lshrrev_b32 v28, 4, v0
  v_lshrrev_b32 v29, 1, v0
  v_and_b32 v30, 1, v0
  v_lshlrev_b32 v26, 8, v27
  v_lshl_add_u32 v26, v28, 4, v26
  s_cmp_eq_u32 s42, 3
  s_cbranch_scc1 L_service
  s_lshl_b32 s46, s42, 1
  v_lshlrev_b32 v25, 2, v29
  v_add3_u32 v29, v25, v30, s46
  s_lshl_b32 s44, s40, 9
  v_lshl_add_u32 v25, v29, 2, s44
  s_lshl_b32 s49, s40, 2
  s_lshl_b32 s62, s2, 12
  s_lshl_b32 s55, s42, 13
  s_lshl_b32 s63, s41, 8
  v_add_u32 v9, 0, v28
  v_xor_b32 v10, v27, v9
  v_lshlrev_b32 v9, 11, v9
  v_lshl_add_u32 v1, v10, 4, v9
  v_add_u32 v9, 4, v28
  v_xor_b32 v10, v27, v9
  v_lshlrev_b32 v9, 11, v9
  v_lshl_add_u32 v2, v10, 4, v9
  v_subrev_u32 v2, 1024, v2
  v_add_u32 v9, 8, v28
  v_xor_b32 v10, v27, v9
  v_lshlrev_b32 v9, 11, v9
  v_lshl_add_u32 v3, v10, 4, v9
  v_subrev_u32 v3, 2048, v3
  v_add_u32 v9, 12, v28
  v_xor_b32 v10, v27, v9
  v_lshlrev_b32 v9, 11, v9
  v_lshl_add_u32 v4, v10, 4, v9
  v_subrev_u32 v4, 3072, v4
  v_lshlrev_b32 v9, 13, v28
  v_lshl_add_u32 v9, v27, 4, v9
  v_add_u32 v10, 0x1000, v9
  s_mov_b32 s26, 16384
  s_mov_b32 s27, 0x00020000
  s_waitcnt lgkmcnt(0)
  s_mov_b32 s24, s10
  s_mov_b32 s25, s11
  buffer_load_dword v11, v25, s[24:27], 0 offen
  s_load_dword s43, s[12:13], s49
  s_mov_b32 s28, s4
  s_mov_b32 s29, s5
  s_mov_b32 s30, 1048576
  s_mov_b32 s31, 0x00020000
  buffer_load_dwordx4 v[32:35], v26, s[28:31], s62 offen offset:0
  buffer_load_dwordx4 v[36:39], v26, s[28:31], s62 offen offset:64
  buffer_load_dwordx4 v[40:43], v26, s[28:31], s62 offen offset:128
  buffer_load_dwordx4 v[44:47], v26, s[28:31], s62 offen offset:192
  s_mov_b32 s16, s6
  s_mov_b32 s17, s7
  s_mov_b32 s18, 134348800
  s_mov_b32 s19, 0x00020000
  s_mov_b32 s20, s8
  s_mov_b32 s21, s9
  s_mov_b32 s22, 134348800
  s_mov_b32 s23, 0x00020000
  s_mov_b32 s59, 0
  s_mov_b32 s97, 1
  s_mov_b32 s46, 0
  s_barrier
  s_cmp_eq_u32 s42, 2
  s_cbranch_scc1 L_consts
  s_waitcnt vmcnt(4)
  v_lshlrev_b32 v11, 15, v11
  v_add_u32 v11, s63, v11
  s_nop 0
L_issue:
  v_readlane_b32 s47, v11, s46
  s_add_u32 s46, s46, 1
  v_readlane_b32 s48, v11, s46
  s_add_u32 s46, s46, 1
  s_nop 1
  s_add_u32 m0, s55, 0
  s_nop 0
  buffer_load_dwordx4 v1, s[16:19], s47 offen offset:0 nt lds
  buffer_load_dwordx4 v2, s[16:19], s47 offen offset:1024 nt lds
  buffer_load_dwordx4 v3, s[16:19], s47 offen offset:2048 nt lds
  buffer_load_dwordx4 v4, s[16:19], s47 offen offset:3072 nt lds
  s_add_u32 m0, s55, 4096
  s_nop 0
  buffer_load_dwordx4 v1, s[16:19], s48 offen offset:0 nt lds
  buffer_load_dwordx4 v2, s[16:19], s48 offen offset:1024 nt lds
  buffer_load_dwordx4 v3, s[16:19], s48 offen offset:2048 nt lds
  buffer_load_dwordx4 v4, s[16:19], s48 offen offset:3072 nt lds
  buffer_load_dwordx4 v[156:159], v9, s[20:23], s47 offen offset:0 nt
  buffer_load_dwordx4 v[160:163], v9, s[20:23], s47 offen offset:2048 nt
  buffer_load_dwordx4 v[164:167], v10, s[20:23], s47 offen offset:0 nt
  buffer_load_dwordx4 v[168:171], v10, s[20:23], s47 offen offset:2048 nt
  buffer_load_dwordx4 v[172:175], v9, s[20:23], s48 offen offset:0 nt
  buffer_load_dwordx4 v[176:179], v9, s[20:23], s48 offen offset:2048 nt
  buffer_load_dwordx4 v[180:183], v10, s[20:23], s48 offen offset:0 nt
  buffer_load_dwordx4 v[184:187], v10, s[20:23], s48 offen offset:2048 nt
  s_cmp_lg_u32 s59, 0
  s_cbranch_scc1 L_loop
  s_cmp_eq_u32 s97, 1
  s_cbranch_scc0 L_phase_end
L_consts:
  v_lshlrev_b32 v30, 8, v27
  v_add_u32 v30, s55, v30
  v_add_u32 v25, 0, v28
  v_xor_b32 v25, v27, v25
  v_lshl_add_u32 v5, v25, 4, v30
  v_add_u32 v25, 4, v28
  v_xor_b32 v25, v27, v25
  v_lshl_add_u32 v6, v25, 4, v30
  v_add_u32 v25, 8, v28
  v_xor_b32 v25, v27, v25
  v_lshl_add_u32 v7, v25, 4, v30
  v_add_u32 v25, 12, v28
  v_xor_b32 v25, v27, v25
  v_lshl_add_u32 v8, v25, 4, v30
  v_lshlrev_b32 v12, 2, v28
  s_mov_b32 s50, 0x3e0293ee
  s_mov_b32 s51, 0x05040100
  s_mov_b32 s52, 0x07060302
  s_mov_b32 s54, 0xd028965f
  v_mov_b32 v48, 0
  v_mov_b32 v49, 0
  v_mov_b32 v50, 0
  v_mov_b32 v51, 0
  v_mov_b32 v52, 0
  v_mov_b32 v53, 0
  v_mov_b32 v54, 0
  v_mov_b32 v55, 0
  v_mov_b32 v56, 0
  v_mov_b32 v57, 0
  v_mov_b32 v58, 0
  v_mov_b32 v59, 0
  v_mov_b32 v60, 0
  v_mov_b32 v61, 0
  v_mov_b32 v62, 0
  v_mov_b32 v63, 0
  v_mov_b32 v64, 0
  v_mov_b32 v65, 0
  v_mov_b32 v66, 0
  v_mov_b32 v67, 0
  v_mov_b32 v68, 0
  v_mov_b32 v69, 0
  v_mov_b32 v70, 0
  v_mov_b32 v71, 0
  v_mov_b32 v72, 0
  v_mov_b32 v73, 0
  v_mov_b32 v74, 0
  v_mov_b32 v75, 0
  v_mov_b32 v76, 0
  v_mov_b32 v77, 0
  v_mov_b32 v78, 0
  v_mov_b32 v79, 0
  v_mov_b32 v20, 0xff7fffff
  v_mov_b32 v21, 0
  s_waitcnt lgkmcnt(0)
  s_sub_u32 s44, s43, 1
  s_min_u32 s44, s44, 2047
  s_max_i32 s43, s43, 0
  s_lshr_b32 s61, s44, 6
  s_add_u32 s61, s61, 1
  s_sub_u32 s45, s61, s42
  s_add_u32 s45, s45, 1
  s_lshr_b32 s45, s45, 1
  s_lshl_b32 s53, s42, 5
  s_sub_i32 s49, s43, s53
  s_cmp_eq_u32 s42, 2
  s_cselect_b32 s45, 0, s45
  s_cselect_b32 s3, 32, 64
  s_cmp_lg_u32 s45, 0
  s_cbranch_scc1 L_loop
  s_waitcnt vmcnt(0)
  s_call_b64 s[98:99], L_getinfo
  s_mov_b32 s46, 0
  s_cmp_eq_u32 s42, 2
  s_cbranch_scc1 L_phase_end
  s_branch L_issue
L_loop:
  s_add_u32 s53, s45, s59
  s_cmp_lg_u32 s53, s97
  s_cbranch_scc1 L_noinfo
  s_call_b64 s[98:99], L_event
L_noinfo:
  v_readlane_b32 s47, v11, s46
  s_add_u32 s46, s46, 1
  v_readlane_b32 s48, v11, s46
  s_add_u32 s46, s46, 1
  s_waitcnt vmcnt(8)
  ds_read_b128 v[92:95], v5 offset:0
  ds_read_b128 v[108:111], v5 offset:4096
  ds_read_b128 v[96:99], v6 offset:0
  ds_read_b128 v[112:115], v6 offset:4096
  ds_read_b128 v[100:103], v7 offset:0
  ds_read_b128 v[116:119], v7 offset:4096
  ds_read_b128 v[104:107], v8 offset:0
  ds_read_b128 v[120:123], v8 offset:4096
  s_waitcnt lgkmcnt(6)
  v_mfma_f32_16x16x32_bf16 v[80:83], v[92:95], v[32:35], 0
  v_mfma_f32_16x16x32_bf16 v[84:87], v[108:111], v[32:35], 0
  s_waitcnt lgkmcnt(4)
  v_mfma_f32_16x16x32_bf16 v[80:83], v[96:99], v[36:39], v[80:83]
  v_mfma_f32_16x16x32_bf16 v[84:87], v[112:115], v[36:39], v[84:87]
  s_waitcnt lgkmcnt(2)
  v_mfma_f32_16x16x32_bf16 v[80:83], v[100:103], v[40:43], v[80:83]
  v_mfma_f32_16x16x32_bf16 v[84:87], v[116:119], v[40:43], v[84:87]
  s_waitcnt lgkmcnt(0)
  v_mfma_f32_16x16x32_bf16 v[80:83], v[104:107], v[44:47], v[80:83]
  v_mfma_f32_16x16x32_bf16 v[84:87], v[120:123], v[44:47], v[84:87]
  s_add_u32 m0, s55, 0
  s_nop 0
  buffer_load_dwordx4 v1, s[16:19], s47 offen offset:0 nt lds
  buffer_load_dwordx4 v2, s[16:19], s47 offen offset:1024 nt lds
  buffer_load_dwordx4 v3, s[16:19], s47 offen offset:2048 nt lds
  buffer_load_dwordx4 v4, s[16:19], s47 offen offset:3072 nt lds
  s_add_u32 m0, s55, 4096
  s_nop 0
  buffer_load_dwordx4 v1, s[16:19], s48 offen offset:0 nt lds
  buffer_load_dwordx4 v2, s[16:19], s48 offen offset:1024 nt lds
  buffer_load_dwordx4 v3, s[16:19], s48 offen offset:2048 nt lds
  buffer_load_dwordx4 v4, s[16:19], s48 offen offset:3072 nt lds
  s_cmp_ge_i32 s49, 32
  s_cbranch_scc1 L_nomask
  v_sub_u32 v25, s49, v12
  v_mov_b32 v26, s54
  v_cmp_lt_i32 s[72:73], 0, v25
  v_cmp_lt_i32 s[74:75], 1, v25
  v_cmp_lt_i32 s[76:77], 2, v25
  v_cmp_lt_i32 s[78:79], 3, v25
  v_cmp_lt_i32 s[80:81], 16, v25
  v_cmp_lt_i32 s[82:83], 17, v25
  v_cmp_lt_i32 s[84:85], 18, v25
  v_cmp_lt_i32 s[86:87], 19, v25
  s_nop 1
  v_cndmask_b32 v80, v26, v80, s[72:73]
  v_cndmask_b32 v81, v26, v81, s[74:75]
  v_cndmask_b32 v82, v26, v82, s[76:77]
  v_cndmask_b32 v83, v26, v83, s[78:79]
  v_cndmask_b32 v84, v26, v84, s[80:81]
  v_cndmask_b32 v85, v26, v85, s[82:83]
  v_cndmask_b32 v86, v26, v86, s[84:85]
  v_cndmask_b32 v87, v26, v87, s[86:87]
L_nomask:
  s_sub_i32 s49, s49, s3
  v_max3_f32 v25, v80, v81, v82
  v_max3_f32 v26, v83, v84, v85
  v_max3_f32 v25, v25, v86, v87
  v_max_f32 v25, v25, v26
  v_mov_b32 v26, v25
  s_nop 1
  v_permlane32_swap_b32 v25, v26
  s_nop 1
  v_max_f32 v25, v25, v26
  v_mov_b32 v26, v25
  s_nop 1
  v_permlane16_swap_b32 v25, v26
  s_nop 1
  v_max_f32 v25, v25, v26
  v_mul_f32 v25, s50, v25
  v_max_f32 v24, v25, v20
  v_sub_f32 v26, v20, v24
  v_exp_f32 v22, v26
  v_mov_b32 v20, v24
  v_fma_f32 v80, v80, s50, -v24
  v_fma_f32 v81, v81, s50, -v24
  v_fma_f32 v82, v82, s50, -v24
  v_fma_f32 v83, v83, s50, -v24
  v_fma_f32 v84, v84, s50, -v24
  v_fma_f32 v85, v85, s50, -v24
  v_fma_f32 v86, v86, s50, -v24
  v_fma_f32 v87, v87, s50, -v24
  v_exp_f32 v80, v80
  v_exp_f32 v81, v81
  v_exp_f32 v82, v82
  v_exp_f32 v83, v83
  v_exp_f32 v84, v84
  v_exp_f32 v85, v85
  v_exp_f32 v86, v86
  v_exp_f32 v87, v87
  v_pk_mul_f32 v[48:49], v[48:49], v[22:23] op_sel_hi:[1,0]
  v_pk_mul_f32 v[50:51], v[50:51], v[22:23] op_sel_hi:[1,0]
  v_pk_mul_f32 v[52:53], v[52:53], v[22:23] op_sel_hi:[1,0]
  v_pk_mul_f32 v[54:55], v[54:55], v[22:23] op_sel_hi:[1,0]
  v_pk_mul_f32 v[56:57], v[56:57], v[22:23] op_sel_hi:[1,0]
  v_pk_mul_f32 v[58:59], v[58:59], v[22:23] op_sel_hi:[1,0]
  v_pk_mul_f32 v[60:61], v[60:61], v[22:23] op_sel_hi:[1,0]
  v_pk_mul_f32 v[62:63], v[62:63], v[22:23] op_sel_hi:[1,0]
  v_pk_mul_f32 v[64:65], v[64:65], v[22:23] op_sel_hi:[1,0]
  v_pk_mul_f32 v[66:67], v[66:67], v[22:23] op_sel_hi:[1,0]
  v_pk_mul_f32 v[68:69], v[68:69], v[22:23] op_sel_hi:[1,0]
  v_pk_mul_f32 v[70:71], v[70:71], v[22:23] op_sel_hi:[1,0]
  v_pk_mul_f32 v[72:73], v[72:73], v[22:23] op_sel_hi:[1,0]
  v_pk_mul_f32 v[74:75], v[74:75], v[22:23] op_sel_hi:[1,0]
  v_pk_mul_f32 v[76:77], v[76:77], v[22:23] op_sel_hi:[1,0]
  v_pk_mul_f32 v[78:79], v[78:79], v[22:23] op_sel_hi:[1,0]
  s_waitcnt vmcnt(8)
  v_perm_b32 v124, v160, v156, s51
  v_perm_b32 v128, v160, v156, s52
  v_perm_b32 v125, v168, v164, s51
  v_perm_b32 v129, v168, v164, s52
  v_perm_b32 v126, v176, v172, s51
  v_perm_b32 v130, v176, v172, s52
  v_perm_b32 v127, v184, v180, s51
  v_perm_b32 v131, v184, v180, s52
  v_perm_b32 v132, v161, v157, s51
  v_perm_b32 v136, v161, v157, s52
  v_perm_b32 v133, v169, v165, s51
  v_perm_b32 v137, v169, v165, s52
  v_perm_b32 v134, v177, v173, s51
  v_perm_b32 v138, v177, v173, s52
  v_perm_b32 v135, v185, v181, s51
  v_perm_b32 v139, v185, v181, s52
  v_perm_b32 v140, v162, v158, s51
  v_perm_b32 v144, v162, v158, s52
  v_perm_b32 v141, v170, v166, s51
  v_perm_b32 v145, v170, v166, s52
  v_perm_b32 v142, v178, v174, s51
  v_perm_b32 v146, v178, v174, s52
  v_perm_b32 v143, v186, v182, s51
  v_perm_b32 v147, v186, v182, s52
  v_perm_b32 v148, v163, v159, s51
  v_perm_b32 v152, v163, v159, s52
  v_perm_b32 v149, v171, v167, s51
  v_perm_b32 v153, v171, v167, s52
  v_perm_b32 v150, v179, v175, s51
  v_perm_b32 v154, v179, v175, s52
  v_perm_b32 v151, v187, v183, s51
  v_perm_b32 v155, v187, v183, s52
  buffer_load_dwordx4 v[156:159], v9, s[20:23], s47 offen offset:0 nt
  buffer_load_dwordx4 v[160:163], v9, s[20:23], s47 offen offset:2048 nt
  buffer_load_dwordx4 v[164:167], v10, s[20:23], s47 offen offset:0 nt
  buffer_load_dwordx4 v[168:171], v10, s[20:23], s47 offen offset:2048 nt
  buffer_load_dwordx4 v[172:175], v9, s[20:23], s48 offen offset:0 nt
  buffer_load_dwordx4 v[176:179], v9, s[20:23], s48 offen offset:2048 nt
  buffer_load_dwordx4 v[180:183], v10, s[20:23], s48 offen offset:0 nt
  buffer_load_dwordx4 v[184:187], v10, s[20:23], s48 offen offset:2048 nt
  v_cvt_pk_bf16_f32 v88, v80, v81
  v_cvt_pk_bf16_f32 v89, v82, v83
  v_cvt_pk_bf16_f32 v90, v84, v85
  v_cvt_pk_bf16_f32 v91, v86, v87
  v_mul_f32 v21, v21, v22
  v_add_f32 v25, v80, v81
  v_mfma_f32_16x16x32_bf16 v[48:51], v[124:127], v[88:91], v[48:51]
  v_add_f32 v26, v82, v83
  v_add_f32 v27, v84, v85
  v_mfma_f32_16x16x32_bf16 v[52:55], v[128:131], v[88:91], v[52:55]
  v_add_f32 v28, v86, v87
  v_add_f32 v25, v25, v26
  v_mfma_f32_16x16x32_bf16 v[56:59], v[132:135], v[88:91], v[56:59]
  v_add_f32 v27, v27, v28
  v_add_f32 v21, v21, v25
  v_mfma_f32_16x16x32_bf16 v[60:63], v[136:139], v[88:91], v[60:63]
  v_add_f32 v21, v21, v27
  v_mfma_f32_16x16x32_bf16 v[64:67], v[140:143], v[88:91], v[64:67]
  v_mfma_f32_16x16x32_bf16 v[68:71], v[144:147], v[88:91], v[68:71]
  v_mfma_f32_16x16x32_bf16 v[72:75], v[148:151], v[88:91], v[72:75]
  v_mfma_f32_16x16x32_bf16 v[76:79], v[152:155], v[88:91], v[76:79]
  s_sub_u32 s45, s45, 1
  s_cmp_lg_u32 s45, 0
  s_cbranch_scc1 L_loop
L_phase_end:
  v_mov_b32 v26, v21
  s_nop 1
  v_permlane32_swap_b32 v21, v26
  s_nop 1
  v_add_f32 v21, v21, v26
  v_mov_b32 v26, v21
  s_nop 1
  v_permlane16_swap_b32 v21, v26
  s_nop 1
  v_add_f32 v21, v21, v26
  v_and_b32 v27, 15, v0
  v_lshrrev_b32 v28, 4, v0
  s_cmp_lg_u32 s59, 0
  s_cbranch_scc1 L_final
  s_cmp_eq_u32 s42, 2
  s_cbranch_scc1 L_noflush
  s_mul_i32 s53, s42, 9216
  s_add_u32 s53, s53, 24576
  v_mul_u32_u24 v25, 144, v27
  v_mul_u32_u24 v26, 2304, v28
  v_add3_u32 v25, v25, v26, s53
  s_lshl_b32 s53, s42, 3
  s_add_u32 s53, s53, 43008
  v_lshl_add_u32 v26, v27, 4, s53
  ds_write_b64 v26, v[20:21]
  ds_write_b128 v25, v[48:51] offset:0
  ds_write_b128 v25, v[52:55] offset:16
  ds_write_b128 v25, v[56:59] offset:32
  ds_write_b128 v25, v[60:63] offset:48
  ds_write_b128 v25, v[64:67] offset:64
  ds_write_b128 v25, v[68:71] offset:80
  ds_write_b128 v25, v[72:75] offset:96
  ds_write_b128 v25, v[76:79] offset:112
L_noflush:
  v_lshlrev_b32 v26, 4, v0
  v_add_u32 v26, 77568, v26
  s_lshl_b32 s53, s42, 2
  s_add_u32 s53, s53, 81712
  v_mov_b32 v25, s53
  ds_read_b128 v[32:35], v26 offset:0
  ds_read_b128 v[36:39], v26 offset:1024
  ds_read_b128 v[40:43], v26 offset:2048
  ds_read_b128 v[44:47], v26 offset:3072
  s_waitcnt lgkmcnt(4)
  ds_write_b32 v25, v25
  v_mov_b32 v48, 0
  v_mov_b32 v49, 0
  v_mov_b32 v50, 0
  v_mov_b32 v51, 0
  v_mov_b32 v52, 0
  v_mov_b32 v53, 0
  v_mov_b32 v54, 0
  v_mov_b32 v55, 0
  v_mov_b32 v56, 0
  v_mov_b32 v57, 0
  v_mov_b32 v58, 0
  v_mov_b32 v59, 0
  v_mov_b32 v60, 0
  v_mov_b32 v61, 0
  v_mov_b32 v62, 0
  v_mov_b32 v63, 0
  v_mov_b32 v64, 0
  v_mov_b32 v65, 0
  v_mov_b32 v66, 0
  v_mov_b32 v67, 0
  v_mov_b32 v68, 0
  v_mov_b32 v69, 0
  v_mov_b32 v70, 0
  v_mov_b32 v71, 0
  v_mov_b32 v72, 0
  v_mov_b32 v73, 0
  v_mov_b32 v74, 0
  v_mov_b32 v75, 0
  v_mov_b32 v76, 0
  v_mov_b32 v77, 0
  v_mov_b32 v78, 0
  v_mov_b32 v79, 0
  v_mov_b32 v20, 0xff7fffff
  v_mov_b32 v21, 0
  s_mov_b32 s59, 0x1000
  s_mov_b32 s49, s57
  s_mov_b32 s45, s56
  s_waitcnt lgkmcnt(0)
  s_cmp_eq_u32 s45, 0
  s_cbranch_scc1 L_phase_end
  s_cmp_lg_u32 s42, 2
  s_cbranch_scc1 L_loop
  v_mov_b32 v25, 81696
L_xwait:
  s_sleep 2
  ds_read_b32 v26, v25 offset:8
  s_waitcnt lgkmcnt(0)
  v_readfirstlane_b32 s53, v26
  s_nop 0
  s_cmp_eq_u32 s53, 0
  s_cbranch_scc1 L_xwait
  s_branch L_issue
L_event:
  s_cmp_eq_u32 s59, 0
  s_cbranch_scc1 L_getinfo
  s_lshl_b32 s53, s42, 2
  v_mov_b32 v26, s53
  v_add_u32 v26, 81700, v26
  ds_write_b32 v26, v26
  s_setpc_b64 s[98:99]
L_getinfo:
  v_mov_b32 v26, 81664
  s_lshl_b32 s53, s42, 8
  s_add_u32 s53, s53, 68608
  v_lshl_add_u32 v25, v0, 2, s53
  s_lshl_b32 s53, s42, 3
  v_add_u32 v30, s53, v26
L_gi_poll:
  s_sleep 1
  ds_read_b32 v29, v26 offset:32
  s_waitcnt lgkmcnt(0)
  v_readfirstlane_b32 s53, v29
  s_nop 0
  s_cmp_eq_u32 s53, 0
  s_cbranch_scc1 L_gi_poll
  ds_read_b32 v11, v25
  ds_read_b64 v[80:81], v26
  ds_read_b64 v[82:83], v30 offset:8
  s_waitcnt lgkmcnt(0)
  v_readfirstlane_b32 s58, v80
  v_readfirstlane_b32 s97, v81
  v_readfirstlane_b32 s56, v82
  v_readfirstlane_b32 s57, v83
  s_and_b32 s53, s97, 0xffff
  s_lshr_b32 s97, s97, 16
  s_cmp_eq_u32 s42, 0
  s_cselect_b32 s97, s53, s97
  s_cmp_eq_u32 s42, 2
  s_cselect_b32 s97, -1, s97
  s_setpc_b64 s[98:99]
L_final:
  s_mul_i32 s53, s42, 8448
  s_add_u32 s53, s53, 43264
  v_mul_u32_u24 v25, 528, v27
  v_lshl_add_u32 v25, v28, 7, v25
  v_add_u32 v25, s53, v25
  s_lshl_b32 s53, s42, 3
  s_add_u32 s53, s53, 77056
  v_lshl_add_u32 v26, v27, 5, s53
  ds_write_b64 v26, v[20:21]
  ds_write_b128 v25, v[48:51] offset:0
  ds_write_b128 v25, v[52:55] offset:16
  ds_write_b128 v25, v[56:59] offset:32
  ds_write_b128 v25, v[60:63] offset:48
  ds_write_b128 v25, v[64:67] offset:64
  ds_write_b128 v25, v[68:71] offset:80
  ds_write_b128 v25, v[72:75] offset:96
  ds_write_b128 v25, v[76:79] offset:112
  s_lshl_b32 s53, s42, 2
  s_add_u32 s53, s53, 81700
  v_mov_b32 v26, s53
  ds_write_b32 v26, v26
L_b2:
  s_mov_b32 s32, s14
  s_mov_b32 s33, s15
  s_mov_b32 s34, 1048576
  s_mov_b32 s35, 0x00020000
  s_lshl_b32 s53, s42, 2
  v_lshrrev_b32 v27, 5, v0
  v_add_u32 v27, s53, v27
  v_and_b32 v28, 31, v0
  v_mul_u32_u24 v25, 528, v27
  v_lshl_add_u32 v25, v28, 4, v25
  v_add_u32 v25, 43264, v25
  v_lshlrev_b32 v26, 5, v27
  v_add_u32 v26, 77056, v26
  v_lshrrev_b32 v29, 3, v28
  v_and_b32 v28, 7, v28
  v_lshlrev_b32 v27, 8, v27
  v_lshl_add_u32 v27, v29, 6, v27
  v_lshl_add_u32 v27, v28, 1, v27
  s_waitcnt lgkmcnt(0)
  s_barrier
  ds_read_b128 v[92:95], v26 offset:0
  ds_read_b128 v[96:99], v26 offset:16
  ds_read_b128 v[100:103], v26 offset:64
  ds_read_b128 v[104:107], v26 offset:80
  ds_read_b128 v[124:127], v25 offset:0
  ds_read_b128 v[128:131], v25 offset:8448
  ds_read_b128 v[132:135], v25 offset:16896
  ds_read_b128 v[136:139], v25 offset:25344
  ds_read_b128 v[48:51], v25 offset:1056
  ds_read_b128 v[52:55], v25 offset:9504
  ds_read_b128 v[56:59], v25 offset:17952
  ds_read_b128 v[60:63], v25 offset:26400
  s_waitcnt lgkmcnt(8)
  v_max3_f32 v116, v92, v94, v96
  v_max_f32 v116, v116, v98
  v_max3_f32 v118, v100, v102, v104
  v_max_f32 v118, v118, v106
  v_sub_f32 v92, v92, v116
  v_sub_f32 v94, v94, v116
  v_sub_f32 v96, v96, v116
  v_sub_f32 v98, v98, v116
  v_sub_f32 v100, v100, v118
  v_sub_f32 v102, v102, v118
  v_sub_f32 v104, v104, v118
  v_sub_f32 v106, v106, v118
  v_exp_f32 v92, v92
  v_exp_f32 v94, v94
  v_exp_f32 v96, v96
  v_exp_f32 v98, v98
  v_exp_f32 v100, v100
  v_exp_f32 v102, v102
  v_exp_f32 v104, v104
  v_exp_f32 v106, v106
  v_mul_f32 v117, v92, v93
  v_fmac_f32 v117, v94, v95
  v_fmac_f32 v117, v96, v97
  v_fmac_f32 v117, v98, v99
  v_mul_f32 v119, v100, v101
  v_fmac_f32 v119, v102, v103
  v_fmac_f32 v119, v104, v105
  v_fmac_f32 v119, v106, v107
  v_rcp_f32 v117, v117
  v_rcp_f32 v119, v119
  s_waitcnt lgkmcnt(4)
  v_mul_f32 v80, v92, v124
  v_mul_f32 v81, v92, v125
  v_mul_f32 v82, v92, v126
  v_mul_f32 v83, v92, v127
  v_fmac_f32 v80, v94, v128
  v_fmac_f32 v81, v94, v129
  v_fmac_f32 v82, v94, v130
  v_fmac_f32 v83, v94, v131
  v_fmac_f32 v80, v96, v132
  v_fmac_f32 v81, v96, v133
  v_fmac_f32 v82, v96, v134
  v_fmac_f32 v83, v96, v135
  v_fmac_f32 v80, v98, v136
  v_fmac_f32 v81, v98, v137
  v_fmac_f32 v82, v98, v138
  v_fmac_f32 v83, v98, v139
  v_mul_f32 v80, v80, v117
  v_mul_f32 v81, v81, v117
  v_mul_f32 v82, v82, v117
  v_mul_f32 v83, v83, v117
  v_cvt_pk_bf16_f32 v88, v80, v81
  v_cvt_pk_bf16_f32 v89, v82, v83
  buffer_store_short v88, v27, s[32:35], s58 offen offset:0
  buffer_store_short_d16_hi v88, v27, s[32:35], s58 offen offset:16
  buffer_store_short v89, v27, s[32:35], s58 offen offset:32
  buffer_store_short_d16_hi v89, v27, s[32:35], s58 offen offset:48
  s_waitcnt lgkmcnt(0)
  v_mul_f32 v84, v100, v48
  v_mul_f32 v85, v100, v49
  v_mul_f32 v86, v100, v50
  v_mul_f32 v87, v100, v51
  v_fmac_f32 v84, v102, v52
  v_fmac_f32 v85, v102, v53
  v_fmac_f32 v86, v102, v54
  v_fmac_f32 v87, v102, v55
  v_fmac_f32 v84, v104, v56
  v_fmac_f32 v85, v104, v57
  v_fmac_f32 v86, v104, v58
  v_fmac_f32 v87, v104, v59
  v_fmac_f32 v84, v106, v60
  v_fmac_f32 v85, v106, v61
  v_fmac_f32 v86, v106, v62
  v_fmac_f32 v87, v106, v63
  v_mul_f32 v84, v84, v119
  v_mul_f32 v85, v85, v119
  v_mul_f32 v86, v86, v119
  v_mul_f32 v87, v87, v119
  v_cvt_pk_bf16_f32 v90, v84, v85
  v_cvt_pk_bf16_f32 v91, v86, v87
  buffer_store_short v90, v27, s[32:35], s58 offen offset:512
  buffer_store_short_d16_hi v90, v27, s[32:35], s58 offen offset:528
  buffer_store_short v91, v27, s[32:35], s58 offen offset:544
  buffer_store_short_d16_hi v91, v27, s[32:35], s58 offen offset:560
  s_endpgm
L_service:
  s_setprio 3
  v_mov_b32 v36, 0
  v_mov_b32 v16, 0
  v_mov_b32 v17, 0
  v_mov_b32 v25, 81696
  ds_write_b64 v25, v[16:17]
  ds_write_b64 v25, v[16:17] offset:8
  ds_write_b64 v25, v[16:17] offset:16
  ds_write_b64 v25, v[16:17] offset:24
  v_and_b32 v35, 31, v0
  v_lshlrev_b32 v25, 2, v35
  s_movk_i32 s62, 2047
  s_waitcnt lgkmcnt(0)
  s_mov_b32 s16, s12
  s_mov_b32 s17, s13
  s_mov_b32 s18, 128
  s_mov_b32 s19, 0x00020000
  buffer_load_dword v32, v25, s[16:19], 0 offen
  s_memrealtime s[98:99]
  s_barrier
  s_mov_b32 s24, s10
  s_mov_b32 s25, s11
  s_mov_b32 s26, 16384
  s_mov_b32 s27, 0x00020000
  s_mov_b32 s28, s4
  s_mov_b32 s29, s5
  s_mov_b32 s30, 1048576
  s_mov_b32 s31, 0x00020000
  s_mov_b32 s36, s90
  s_mov_b32 s37, s91
  s_mov_b32 s38, 2359296
  s_mov_b32 s39, 0x00020000
  s_xor_b32 s67, s41, 1
  s_waitcnt vmcnt(0)
  v_add_u32 v33, -1, v32
  v_min_u32 v33, s62, v33
  v_max_i32 v32, 0, v32
  v_lshl_add_u32 v35, v33, 5, v35
  s_nop 0
  v_readlane_b32 s56, v35, 0
  v_readlane_b32 s57, v35, 1
  v_readlane_b32 s58, v35, 2
  v_readlane_b32 s59, v35, 3
  v_readlane_b32 s60, v35, 4
  v_readlane_b32 s61, v35, 5
  v_readlane_b32 s62, v35, 6
  v_readlane_b32 s63, v35, 7
  v_cmp_lt_u32 s[72:73], s56, v35
  v_cmp_lt_u32 s[74:75], s57, v35
  v_cmp_lt_u32 s[76:77], s58, v35
  v_cmp_lt_u32 s[78:79], s59, v35
  v_cmp_lt_u32 s[80:81], s60, v35
  v_cmp_lt_u32 s[82:83], s61, v35
  v_cmp_lt_u32 s[84:85], s62, v35
  v_cmp_lt_u32 s[86:87], s63, v35
  v_addc_co_u32 v36, vcc, 0, v36, s[72:73]
  v_addc_co_u32 v36, vcc, 0, v36, s[74:75]
  v_addc_co_u32 v36, vcc, 0, v36, s[76:77]
  v_addc_co_u32 v36, vcc, 0, v36, s[78:79]
  v_addc_co_u32 v36, vcc, 0, v36, s[80:81]
  v_addc_co_u32 v36, vcc, 0, v36, s[82:83]
  v_addc_co_u32 v36, vcc, 0, v36, s[84:85]
  v_addc_co_u32 v36, vcc, 0, v36, s[86:87]
  v_readlane_b32 s56, v35, 8
  v_readlane_b32 s57, v35, 9
  v_readlane_b32 s58, v35, 10
  v_readlane_b32 s59, v35, 11
  v_readlane_b32 s60, v35, 12
  v_readlane_b32 s61, v35, 13
  v_readlane_b32 s62, v35, 14
  v_readlane_b32 s63, v35, 15
  v_cmp_lt_u32 s[72:73], s56, v35
  v_cmp_lt_u32 s[74:75], s57, v35
  v_cmp_lt_u32 s[76:77], s58, v35
  v_cmp_lt_u32 s[78:79], s59, v35
  v_cmp_lt_u32 s[80:81], s60, v35
  v_cmp_lt_u32 s[82:83], s61, v35
  v_cmp_lt_u32 s[84:85], s62, v35
  v_cmp_lt_u32 s[86:87], s63, v35
  v_addc_co_u32 v36, vcc, 0, v36, s[72:73]
  v_addc_co_u32 v36, vcc, 0, v36, s[74:75]
  v_addc_co_u32 v36, vcc, 0, v36, s[76:77]
  v_addc_co_u32 v36, vcc, 0, v36, s[78:79]
  v_addc_co_u32 v36, vcc, 0, v36, s[80:81]
  v_addc_co_u32 v36, vcc, 0, v36, s[82:83]
  v_addc_co_u32 v36, vcc, 0, v36, s[84:85]
  v_addc_co_u32 v36, vcc, 0, v36, s[86:87]
  v_readlane_b32 s56, v35, 16
  v_readlane_b32 s57, v35, 17
  v_readlane_b32 s58, v35, 18
  v_readlane_b32 s59, v35, 19
  v_readlane_b32 s60, v35, 20
  v_readlane_b32 s61, v35, 21
  v_readlane_b32 s62, v35, 22
  v_readlane_b32 s63, v35, 23
  v_cmp_lt_u32 s[72:73], s56, v35
  v_cmp_lt_u32 s[74:75], s57, v35
  v_cmp_lt_u32 s[76:77], s58, v35
  v_cmp_lt_u32 s[78:79], s59, v35
  v_cmp_lt_u32 s[80:81], s60, v35
  v_cmp_lt_u32 s[82:83], s61, v35
  v_cmp_lt_u32 s[84:85], s62, v35
  v_cmp_lt_u32 s[86:87], s63, v35
  v_addc_co_u32 v36, vcc, 0, v36, s[72:73]
  v_addc_co_u32 v36, vcc, 0, v36, s[74:75]
  v_addc_co_u32 v36, vcc, 0, v36, s[76:77]
  v_addc_co_u32 v36, vcc, 0, v36, s[78:79]
  v_addc_co_u32 v36, vcc, 0, v36, s[80:81]
  v_addc_co_u32 v36, vcc, 0, v36, s[82:83]
  v_addc_co_u32 v36, vcc, 0, v36, s[84:85]
  v_addc_co_u32 v36, vcc, 0, v36, s[86:87]
  v_readlane_b32 s56, v35, 24
  v_readlane_b32 s57, v35, 25
  v_readlane_b32 s58, v35, 26
  v_readlane_b32 s59, v35, 27
  v_readlane_b32 s60, v35, 28
  v_readlane_b32 s61, v35, 29
  v_readlane_b32 s62, v35, 30
  v_readlane_b32 s63, v35, 31
  v_cmp_lt_u32 s[72:73], s56, v35
  v_cmp_lt_u32 s[74:75], s57, v35
  v_cmp_lt_u32 s[76:77], s58, v35
  v_cmp_lt_u32 s[78:79], s59, v35
  v_cmp_lt_u32 s[80:81], s60, v35
  v_cmp_lt_u32 s[82:83], s61, v35
  v_cmp_lt_u32 s[84:85], s62, v35
  v_cmp_lt_u32 s[86:87], s63, v35
  v_addc_co_u32 v36, vcc, 0, v36, s[72:73]
  v_addc_co_u32 v36, vcc, 0, v36, s[74:75]
  v_addc_co_u32 v36, vcc, 0, v36, s[76:77]
  v_addc_co_u32 v36, vcc, 0, v36, s[78:79]
  v_addc_co_u32 v36, vcc, 0, v36, s[80:81]
  v_addc_co_u32 v36, vcc, 0, v36, s[82:83]
  v_addc_co_u32 v36, vcc, 0, v36, s[84:85]
  v_addc_co_u32 v36, vcc, 0, v36, s[86:87]
  s_nop 0
  v_readlane_b32 s53, v36, s40
  s_nop 0
  s_sub_u32 s53, 31, s53
  v_cmp_eq_u32 vcc, s53, v36
  v_readlane_b32 s44, v33, s40
  s_nop 3
  s_ff1_i32_b64 s66, vcc
  s_and_b32 s66, s66, 31
  v_cmp_eq_u32 vcc, 31, v36
  v_readlane_b32 s69, v33, s66
  v_readlane_b32 s71, v32, s66
  s_nop 2
  s_ff1_i32_b64 s53, vcc
  v_readlane_b32 s97, v33, s53
  s_lshr_b32 s61, s44, 6
  s_add_u32 s61, s61, 1
  s_lshr_b32 s44, s44, 4
  s_add_u32 s44, s44, 1
  s_lshr_b32 s68, s69, 6
  s_add_u32 s68, s68, 1
  s_lshr_b32 s65, s69, 5
  s_add_u32 s70, s65, 1
  s_sub_u32 s70, s70, s68
  s_lshr_b32 s69, s69, 4
  s_add_u32 s69, s69, 1
  s_add_u32 s45, s61, s70
  s_add_u32 s3, s45, 0
  s_and_b32 s3, s3, 1
  s_add_u32 s3, s3, 0
  s_min_u32 s3, s3, s70
  s_sub_u32 s70, s70, s3
  s_add_u32 s65, s68, s70
  s_add_u32 s49, s68, s70
  s_lshl_b32 s49, s49, 1
  s_min_u32 s49, s49, s69
  s_lshr_b32 s97, s97, 6
  s_add_u32 s97, s97, 1
  s_mul_i32 s53, s45, 230
  s_lshr_b32 s53, s53, 8
  s_mov_b32 s97, s53
  s_add_u32 s97, s97, 1
  s_lshr_b32 s97, s97, 1
  s_lshl_b32 s62, s40, 9
  s_lshl_b32 s63, s66, 9
  s_lshl_b32 s60, s66, 3
  s_add_u32 s60, s60, s67
  s_lshl_b32 s58, s60, 12
  s_add_u32 s56, s61, 1
  s_lshr_b32 s56, s56, 1
  s_add_u32 s53, s61, 0
  s_and_b32 s53, s53, 1
  s_sub_u32 s64, s70, s53
  s_add_u32 s64, s64, 1
  s_lshr_b32 s64, s64, 1
  v_mov_b32 v82, s64
  s_cmp_gt_u32 s97, s56
  s_cselect_b32 s59, 1, 0
  s_add_u32 s64, s64, s56
  s_sub_i32 s97, s64, s97
  s_add_u32 s97, s97, 0x1000
  s_add_u32 s53, s53, s68
  s_lshl_b32 s64, s53, 5
  s_sub_i32 s64, s71, s64
  v_mov_b32 v83, s64
  s_lshl_b32 s64, s56, 1
  s_sub_u32 s53, s53, s64
  v_cmp_gt_u32 vcc, s56, v29
  v_mov_b32 v25, s53
  v_mov_b32 v22, s49
  v_mov_b32 v23, 0
  v_cndmask_b32 v25, v25, v23, vcc
  v_lshl_add_u32 v25, v29, 1, v25
  v_lshl_add_u32 v40, v25, 1, v30
  v_mov_b32 v23, s44
  v_cndmask_b32 v48, v22, v23, vcc
  v_mov_b32 v22, s63
  v_mov_b32 v23, s62
  v_cndmask_b32 v25, v22, v23, vcc
  v_lshl_add_u32 v25, v40, 2, v25
  buffer_load_dword v44, v25, s[24:27], 0 offen
  v_mov_b32 v22, s67
  v_mov_b32 v23, s41
  v_cndmask_b32 v52, v22, v23, vcc
  v_lshlrev_b32 v52, 8, v52
  s_add_u32 s56, s61, 0
  s_lshr_b32 s56, s56, 1
  s_add_u32 s53, s61, 1
  s_and_b32 s53, s53, 1
  s_sub_u32 s64, s70, s53
  s_add_u32 s64, s64, 1
  s_lshr_b32 s64, s64, 1
  v_mov_b32 v84, s64
  s_add_u32 s46, s3, 1
  s_min_u32 s64, s64, s46
  s_add_u32 s64, s64, 0x1000
  s_lshl_b32 s64, s64, 16
  s_or_b32 s97, s97, s64
  s_add_u32 s53, s53, s68
  s_lshl_b32 s64, s53, 5
  s_sub_i32 s64, s71, s64
  v_mov_b32 v85, s64
  s_lshl_b32 s64, s56, 1
  s_sub_u32 s53, s53, s64
  v_cmp_gt_u32 vcc, s56, v29
  v_mov_b32 v25, s53
  v_mov_b32 v22, s49
  v_mov_b32 v23, 1
  v_cndmask_b32 v25, v25, v23, vcc
  v_lshl_add_u32 v25, v29, 1, v25
  v_lshl_add_u32 v41, v25, 1, v30
  v_mov_b32 v23, s44
  v_cndmask_b32 v49, v22, v23, vcc
  v_mov_b32 v22, s63
  v_mov_b32 v23, s62
  v_cndmask_b32 v25, v22, v23, vcc
  v_lshl_add_u32 v25, v41, 2, v25
  buffer_load_dword v45, v25, s[24:27], 0 offen
  v_mov_b32 v22, s67
  v_mov_b32 v23, s41
  v_cndmask_b32 v53, v22, v23, vcc
  v_lshlrev_b32 v53, 8, v53
  s_lshl_b32 s53, s65, 1
  v_add_u32 v42, s53, v0
  v_lshlrev_b32 v25, 2, v42
  buffer_load_dword v46, v25, s[24:27], s63 offen
  v_mov_b32 v50, s69
  s_lshl_b32 s53, s67, 8
  v_mov_b32 v54, s53
  v_mov_b32 v86, s3
  s_lshl_b32 s53, s65, 5
  s_sub_i32 s53, s71, s53
  v_mov_b32 v87, s53
  s_mov_b32 m0, 77568
  s_nop 0
  buffer_load_dwordx4 v26, s[28:31], s58 offen offset:0 lds
  s_mov_b32 m0, 78528
  s_nop 0
  buffer_load_dwordx4 v26, s[28:31], s58 offen offset:64 lds
  s_mov_b32 m0, 79488
  s_nop 0
  buffer_load_dwordx4 v26, s[28:31], s58 offen offset:128 lds
  s_mov_b32 m0, 80448
  s_nop 0
  buffer_load_dwordx4 v26, s[28:31], s58 offen offset:192 lds
  v_mov_b32 v80, s58
  v_mov_b32 v81, s97
  v_mov_b32 v35, 81664
  ds_write_b128 v35, v[80:83]
  ds_write_b128 v35, v[84:87] offset:16
  v_lshlrev_b32 v25, 2, v0
  v_add_u32 v25, 68608, v25
  v_mov_b32 v22, 0x10000000
  v_cmp_lt_u32 vcc, v40, v48
  s_waitcnt vmcnt(6)
  v_lshl_add_u32 v44, v44, 15, v52
  v_cndmask_b32 v44, v22, v44, vcc
  ds_write_b32 v25, v44 offset:0
  v_cmp_lt_u32 vcc, v41, v49
  s_waitcnt vmcnt(5)
  v_lshl_add_u32 v45, v45, 15, v53
  v_cndmask_b32 v45, v22, v45, vcc
  ds_write_b32 v25, v45 offset:256
  v_cmp_lt_u32 vcc, v42, v50
  s_waitcnt vmcnt(4)
  v_lshl_add_u32 v46, v46, 15, v54
  v_cndmask_b32 v46, v22, v46, vcc
  ds_write_b32 v25, v46 offset:512
  v_mov_b32 v22, 1
  s_waitcnt vmcnt(0) lgkmcnt(0)
  ds_write_b32 v35, v22 offset:32
  s_or_b32 s98, s98, 1
  v_mov_b32 v14, s98
  v_mov_b32 v15, s99
  s_mov_b64 s[72:73], exec
  s_cmp_lg_u32 s2, 0
  s_cbranch_scc1 L_nocas
  s_mov_b64 exec, 1
  global_atomic_cmpswap_x2 v16, v[14:17], s[88:89] sc1
  s_mov_b64 exec, s[72:73]
L_nocas:
  v_mul_u32_u24 v25, 144, v27
  v_mul_u32_u24 v26, 2304, v28
  v_add_u32 v25, v25, v26
  v_add_u32 v25, 24576, v25
  v_lshlrev_b32 v26, 4, v27
  v_add_u32 v26, 43008, v26
  v_lshlrev_b32 v29, 4, v0
  v_lshlrev_b32 v30, 2, v0
  s_mul_i32 s62, s2, 9216
  s_mul_i32 s63, s60, 9216
L_fwait:
  s_sleep 2
  ds_read_b96 v[32:34], v35 offset:48
  s_waitcnt lgkmcnt(0)
  v_min_u32 v32, v32, v33
  v_min_u32 v32, v32, v34
  s_nop 0
  v_readfirstlane_b32 s53, v32
  s_nop 0
  s_cmp_eq_u32 s53, 0
  s_cbranch_scc1 L_fwait
  s_waitcnt vmcnt(0)
  global_load_dwordx2 v[18:19], v16, s[88:89] sc1
  ds_read_b128 v[32:35], v26
  ds_read_b128 v[72:75], v25 offset:0
  ds_read_b128 v[76:79], v25 offset:9216
  ds_read_b128 v[80:83], v25 offset:16
  ds_read_b128 v[84:87], v25 offset:9232
  ds_read_b128 v[88:91], v25 offset:32
  ds_read_b128 v[92:95], v25 offset:9248
  ds_read_b128 v[96:99], v25 offset:48
  ds_read_b128 v[100:103], v25 offset:9264
  ds_read_b128 v[104:107], v25 offset:64
  ds_read_b128 v[108:111], v25 offset:9280
  ds_read_b128 v[112:115], v25 offset:80
  ds_read_b128 v[116:119], v25 offset:9296
  ds_read_b128 v[120:123], v25 offset:96
  ds_read_b128 v[124:127], v25 offset:9312
  s_waitcnt lgkmcnt(14)
  ds_read_b128 v[128:131], v25 offset:112
  v_max_f32 v20, v32, v34
  v_sub_f32 v32, v32, v20
  v_sub_f32 v34, v34, v20
  v_exp_f32 v32, v32
  v_exp_f32 v34, v34
  s_waitcnt lgkmcnt(13)
  ds_read_b128 v[132:135], v25 offset:9328
  v_mul_f32 v21, v32, v33
  v_fmac_f32 v21, v34, v35
  s_waitcnt lgkmcnt(14)
  v_mul_f32 v40, v32, v72
  v_mul_f32 v41, v32, v73
  v_mul_f32 v42, v32, v74
  v_mul_f32 v43, v32, v75
  v_fmac_f32 v40, v34, v76
  v_fmac_f32 v41, v34, v77
  v_fmac_f32 v42, v34, v78
  v_fmac_f32 v43, v34, v79
  s_waitcnt lgkmcnt(12)
  v_mul_f32 v44, v32, v80
  v_mul_f32 v45, v32, v81
  v_mul_f32 v46, v32, v82
  v_mul_f32 v47, v32, v83
  v_fmac_f32 v44, v34, v84
  v_fmac_f32 v45, v34, v85
  v_fmac_f32 v46, v34, v86
  v_fmac_f32 v47, v34, v87
  s_waitcnt lgkmcnt(10)
  v_mul_f32 v48, v32, v88
  v_mul_f32 v49, v32, v89
  v_mul_f32 v50, v32, v90
  v_mul_f32 v51, v32, v91
  v_fmac_f32 v48, v34, v92
  v_fmac_f32 v49, v34, v93
  v_fmac_f32 v50, v34, v94
  v_fmac_f32 v51, v34, v95
  s_waitcnt lgkmcnt(8)
  v_mul_f32 v52, v32, v96
  v_mul_f32 v53, v32, v97
  v_mul_f32 v54, v32, v98
  v_mul_f32 v55, v32, v99
  v_fmac_f32 v52, v34, v100
  v_fmac_f32 v53, v34, v101
  v_fmac_f32 v54, v34, v102
  v_fmac_f32 v55, v34, v103
  s_waitcnt lgkmcnt(6)
  v_mul_f32 v56, v32, v104
  v_mul_f32 v57, v32, v105
  v_mul_f32 v58, v32, v106
  v_mul_f32 v59, v32, v107
  v_fmac_f32 v56, v34, v108
  v_fmac_f32 v57, v34, v109
  v_fmac_f32 v58, v34, v110
  v_fmac_f32 v59, v34, v111
  s_waitcnt lgkmcnt(4)
  v_mul_f32 v60, v32, v112
  v_mul_f32 v61, v32, v113
  v_mul_f32 v62, v32, v114
  v_mul_f32 v63, v32, v115
  v_fmac_f32 v60, v34, v116
  v_fmac_f32 v61, v34, v117
  v_fmac_f32 v62, v34, v118
  v_fmac_f32 v63, v34, v119
  s_waitcnt lgkmcnt(2)
  v_mul_f32 v64, v32, v120
  v_mul_f32 v65, v32, v121
  v_mul_f32 v66, v32, v122
  v_mul_f32 v67, v32, v123
  v_fmac_f32 v64, v34, v124
  v_fmac_f32 v65, v34, v125
  v_fmac_f32 v66, v34, v126
  v_fmac_f32 v67, v34, v127
  s_waitcnt lgkmcnt(0)
  v_mul_f32 v68, v32, v128
  v_mul_f32 v69, v32, v129
  v_mul_f32 v70, v32, v130
  v_mul_f32 v71, v32, v131
  v_fmac_f32 v68, v34, v132
  v_fmac_f32 v69, v34, v133
  v_fmac_f32 v70, v34, v134
  v_fmac_f32 v71, v34, v135
  s_waitcnt vmcnt(0)
  v_readfirstlane_b32 s64, v18
  v_readfirstlane_b32 s65, v19
  s_nop 0
  s_cmp_lg_u32 s64, 0
  s_cbranch_scc1 L_havenonce
  s_mov_b64 exec, 1
  global_atomic_cmpswap_x2 v[18:19], v16, v[14:17], s[88:89] sc0 sc1
  s_mov_b64 exec, s[72:73]
  s_waitcnt vmcnt(0)
  v_readfirstlane_b32 s64, v18
  v_readfirstlane_b32 s65, v19
  s_nop 0
  s_cmp_lg_u32 s64, 0
  s_cselect_b32 s64, s64, s98
  s_cselect_b32 s65, s65, s99
L_havenonce:
  s_mov_b32 s98, s64
  s_mov_b32 s99, s65
  v_mov_b32 v14, s64
  v_mov_b32 v15, s65
  s_cmp_eq_u32 s59, 0
  s_cbranch_scc1 L_publish
  v_mov_b32 v25, 81696
L_trig:
  s_sleep 2
  ds_read_b32 v26, v25 offset:4
  s_waitcnt lgkmcnt(0)
  v_readfirstlane_b32 s53, v26
  s_nop 0
  s_cmp_eq_u32 s53, 0
  s_cbranch_scc1 L_trig
L_publish:
  s_add_u32 s64, s62, 4096
  s_add_u32 s65, s62, 8192
  buffer_store_dwordx4 v[40:43], v29, s[36:39], s62 offen offset:0 sc1
  buffer_store_dwordx4 v[44:47], v29, s[36:39], s62 offen offset:1024 sc1
  buffer_store_dwordx4 v[48:51], v29, s[36:39], s62 offen offset:2048 sc1
  buffer_store_dwordx4 v[52:55], v29, s[36:39], s62 offen offset:3072 sc1
  buffer_store_dwordx4 v[56:59], v29, s[36:39], s64 offen offset:0 sc1
  buffer_store_dwordx4 v[60:63], v29, s[36:39], s64 offen offset:1024 sc1
  buffer_store_dwordx4 v[64:67], v29, s[36:39], s64 offen offset:2048 sc1
  buffer_store_dwordx4 v[68:71], v29, s[36:39], s64 offen offset:3072 sc1
  buffer_store_dword v20, v30, s[36:39], s65 offen sc1
  buffer_store_dword v21, v30, s[36:39], s65 offen offset:256 sc1
  s_add_u32 s64, s63, 8704
  s_waitcnt vmcnt(0)
  s_mov_b64 exec, 1
  buffer_store_dwordx2 v[14:15], v16, s[36:39], s65 offen offset:512 sc1
  s_mov_b32 s65, 0x40000
L_poll:
  buffer_load_dwordx2 v[18:19], v16, s[36:39], s64 offen sc1
  s_waitcnt vmcnt(0)
  v_readfirstlane_b32 s56, v18
  v_readfirstlane_b32 s57, v19
  s_nop 0
  s_cmp_eq_u64 s[56:57], s[98:99]
  s_cbranch_scc1 L_got
  s_sleep 2
  s_sub_u32 s65, s65, 1
  s_cmp_lg_u32 s65, 0
  s_cbranch_scc1 L_poll
L_got:
  s_mov_b64 exec, s[72:73]
  s_add_u32 s64, s63, 8192
  buffer_load_dword v20, v30, s[36:39], s64 offen sc1
  buffer_load_dword v21, v30, s[36:39], s64 offen offset:256 sc1
  s_add_u32 s64, s63, 4096
  buffer_load_dwordx4 v[40:43], v29, s[36:39], s63 offen offset:0 sc1
  buffer_load_dwordx4 v[44:47], v29, s[36:39], s63 offen offset:1024 sc1
  buffer_load_dwordx4 v[48:51], v29, s[36:39], s63 offen offset:2048 sc1
  buffer_load_dwordx4 v[52:55], v29, s[36:39], s63 offen offset:3072 sc1
  buffer_load_dwordx4 v[56:59], v29, s[36:39], s64 offen offset:0 sc1
  buffer_load_dwordx4 v[60:63], v29, s[36:39], s64 offen offset:1024 sc1
  buffer_load_dwordx4 v[64:67], v29, s[36:39], s64 offen offset:2048 sc1
  buffer_load_dwordx4 v[68:71], v29, s[36:39], s64 offen offset:3072 sc1
  v_mul_u32_u24 v25, 528, v27
  v_lshl_add_u32 v25, v28, 7, v25
  v_add_u32 v25, 68608, v25
  v_lshlrev_b32 v26, 5, v27
  v_add_u32 v26, 77080, v26
  s_waitcnt vmcnt(8)
  ds_write_b64 v26, v[20:21]
  s_waitcnt vmcnt(7)
  ds_write_b128 v25, v[40:43] offset:0
  s_waitcnt vmcnt(6)
  ds_write_b128 v25, v[44:47] offset:16
  s_waitcnt vmcnt(5)
  ds_write_b128 v25, v[48:51] offset:32
  s_waitcnt vmcnt(4)
  ds_write_b128 v25, v[52:55] offset:48
  s_waitcnt vmcnt(3)
  ds_write_b128 v25, v[56:59] offset:64
  s_waitcnt vmcnt(2)
  ds_write_b128 v25, v[60:63] offset:80
  s_waitcnt vmcnt(1)
  ds_write_b128 v25, v[64:67] offset:96
  s_waitcnt vmcnt(0)
  ds_write_b128 v25, v[68:71] offset:112
  s_branch L_b2
L_end:
  s_endpgm
.section .rodata,"a"
.p2align 6
.amdhsa_kernel standalone__paged_block_table_kv_pagedattention__sampling_kernel
  .amdhsa_next_free_vgpr 188
  .amdhsa_next_free_sgpr 102
  .amdhsa_accum_offset 188
  .amdhsa_group_segment_fixed_size 0
  .amdhsa_kernarg_size 64
  .amdhsa_user_sgpr_count 2
  .amdhsa_user_sgpr_kernarg_segment_ptr 1
  .amdhsa_system_sgpr_workgroup_id_x 1
.end_amdhsa_kernel
```
